```python
import torch

def _softmax(x, axis=-1):
    return torch.softmax(x, dim=axis)
def _gelu(x):
    return torch.nn.functional.gelu(x, approximate="tanh")
def _silu(x):
    return torch.nn.functional.silu(x)
def _sigmoid(x):
    return torch.sigmoid(x)
def _layernorm(x, axis=-1, eps=1e-5):
    m = x.mean(dim=axis, keepdim=True)
    v = x.var(dim=axis, keepdim=True, unbiased=False)
    return (x - m) / torch.sqrt(v + eps)
def _scatter_add(tgt, idx, src, axis=0):
    return tgt.clone().index_add_(axis, idx, src)
def _segment_sum(src, seg, n):
    out = torch.zeros((n,) + src.shape[1:], dtype=src.dtype)
    return out.index_add_(0, seg, src)
def _pad(x, pw):
    flat = tuple(v for pair in reversed(pw) for v in pair)
    return torch.nn.functional.pad(x, flat)

kernel_name = 'gated_mix__compressed_kv_cla__glu_gated_reglu__decode'

def setup_inputs():

    _w = (lambda a: (lambda t: t.to(torch.bfloat16) if t.is_floating_point() else t)(torch.as_tensor(a)))
    def _A_setup():
        B, H, Sq, Sk, D, M = 4, 32, 1, 4096, 128, 512
        Dc = 4 * D
        return {
            "x": _w((lambda *s: torch.randn(*s, dtype=torch.bfloat16) * 0.05)(B, Sq, M)),
            "c_kv": _w((lambda *s: torch.randn(*s, dtype=torch.bfloat16) * 0.4)(B, Sk, Dc)),
            "w_q": _w((lambda *s: torch.randn(*s, dtype=torch.bfloat16) * 6.4)(M, H, D) * (M ** -0.5)),
            "w_uk": _w((lambda *s: torch.randn(*s, dtype=torch.bfloat16) * 6.4)(Dc, H, D) * (Dc ** -0.5)),
            "w_uv": _w((lambda *s: torch.randn(*s, dtype=torch.bfloat16) * 0.4)(Dc, H, D) * (Dc ** -0.5)),
            "w_o": _w((lambda *s: torch.randn(*s, dtype=torch.bfloat16) * 0.4)(H, D, M) * ((H * D) ** -0.5)),
        }
    _A_in = _A_setup()

    def _B_setup():
        B, S, D, F = 4, 1, 512, 1792
        return {
            "x": _w((lambda *s: torch.randn(*s, dtype=torch.bfloat16) * 0.05)(B, S, D)),
            "W_gate": _w((lambda *s: torch.randn(*s, dtype=torch.bfloat16) * 0.8)(D, F) * (2.0 / D) ** 0.5),
            "W_up": _w((lambda *s: torch.randn(*s, dtype=torch.bfloat16) * 0.8)(D, F) * (2.0 / D) ** 0.5),
            "W_down": _w((lambda *s: torch.randn(*s, dtype=torch.bfloat16) * 0.8)(F, D) * (1.0 / F) ** 0.5),
        }
    _B_in = _B_setup()

    return {
        "A_x": _A_in["x"],
        "A_c_kv": _A_in["c_kv"],
        "A_w_q": _A_in["w_q"],
        "A_w_uk": _A_in["w_uk"],
        "A_w_uv": _A_in["w_uv"],
        "A_w_o": _A_in["w_o"],
        "B_x": _B_in["x"],
        "B_W_gate": _B_in["W_gate"],
        "B_W_up": _B_in["W_up"],
        "B_W_down": _B_in["W_down"],
        "gate_w": _w((lambda *s: torch.randn(*s, dtype=torch.bfloat16) * 0.05)(512) * 16.0),
    }

def reference(A_x, A_c_kv, A_w_q, A_w_uk, A_w_uv, A_w_o, B_x, B_W_gate, B_W_up, B_W_down, gate_w):
    def _A_ref(x, c_kv, w_q, w_uk, w_uv, w_o):
        B, Sq, M = x.shape[0], x.shape[1], x.shape[2]
        Sk = c_kv.shape[1]
        H, D = w_q.shape[1], w_q.shape[2]
        q = torch.einsum("bqm,mhd->bhqd", x, w_q)
        k = torch.einsum("bkc,chd->bhkd", c_kv, w_uk)
        v = torch.einsum("bkc,chd->bhkd", c_kv, w_uv)
        scores = torch.einsum("bhqd,bhkd->bhqk", q, k) * (D ** -0.5)
        off = Sk - Sq
        qi = torch.arange(Sq)[:, None]
        kj = torch.arange(Sk)[None, :]
        cmask = kj <= (qi + off)
        scores = torch.where(cmask[None, None], scores, -1e9)
        p = _softmax(scores, axis=-1)
        ctx = torch.einsum("bhqk,bhkd->bhqd", p, v)
        return torch.einsum("bhqd,hdm->bqm", ctx, w_o)

    def _B_ref(x, W_gate, W_up, W_down):
        gate = torch.einsum("bsd,df->bsf", x, W_gate)
        up = torch.einsum("bsd,df->bsf", x, W_up)
        gate = gate * (lambda x, dt: x.to(dt))(gate > 0, gate.dtype)
        h = gate * up
        return torch.einsum("bsf,fd->bsd", h, W_down)

    x = A_x
    g = _sigmoid((x * gate_w).sum(-1, keepdims=True))
    a = _A_ref(x, A_c_kv, A_w_q, A_w_uk, A_w_uv, A_w_o)
    b = _B_ref(x, B_W_gate, B_W_up, B_W_down)
    return g * a + (1 - g) * b
```

```asm
; @launch kernel=k1_prep_kernel grid=(156,1,1) block=(256,1,1) lds=147456
; @launch kernel=k2_attn_kernel grid=(256,1,1) block=(256,1,1) lds=155648
; @launch kernel=k3_proj_kernel grid=(256,1,1) block=(256,1,1) lds=163840
; @launch kernel=k4_sum_kernel grid=(32,1,1) block=(256,1,1) lds=1024
.amdgcn_target "amdgcn-amd-amdhsa--gfx950"
.text
.globl k1_prep_kernel
.p2align 8
.type k1_prep_kernel,@function
k1_prep_kernel:
    s_cmp_ge_u32 s2, 156
    s_cbranch_scc1 K1_done
    s_load_dwordx2 s[4:5], s[0:1], 0
    s_load_dwordx2 s[6:7], s[0:1], 16
    s_load_dwordx2 s[8:9], s[0:1], 24
    s_load_dwordx2 s[10:11], s[0:1], 56
    s_load_dwordx2 s[12:13], s[0:1], 64
    s_load_dwordx2 s[14:15], s[0:1], 104
    v_and_b32 v1, 63, v0
    v_lshrrev_b32 v2, 6, v0
    v_lshrrev_b32 v3, 4, v1
    v_and_b32 v4, 15, v1
    v_lshrrev_b32 v5, 2, v4
    v_and_b32 v6, 3, v4
    v_readfirstlane_b32 s20, v2
    s_waitcnt lgkmcnt(0)
    s_mov_b32 s24, s4
    s_and_b32 s25, s5, 0xffff
    s_mov_b32 s26, 4096
    s_mov_b32 s27, 0x00020000
    s_mov_b32 s28, s6
    s_and_b32 s29, s7, 0xffff
    s_mov_b32 s30, 4194304
    s_mov_b32 s31, 0x00020000
    s_mov_b32 s32, s8
    s_and_b32 s33, s9, 0xffff
    s_mov_b32 s34, 4194304
    s_mov_b32 s35, 0x00020000
    s_mov_b32 s36, s10
    s_and_b32 s37, s11, 0xffff
    s_mov_b32 s38, 1835008
    s_mov_b32 s39, 0x00020000
    s_mov_b32 s40, s12
    s_and_b32 s41, s13, 0xffff
    s_mov_b32 s42, 1835008
    s_mov_b32 s43, 0x00020000
    s_mov_b32 s44, s14
    s_and_b32 s45, s15, 0xffff
    s_mov_b32 s46, 20971520
    s_mov_b32 s47, 0x00020000
    v_lshlrev_b32 v8, 4, v1
    s_lshl_b32 s55, s20, 12
    s_add_u32 s56, s55, 131072
    s_mov_b32 s52, 0
K1_xl:
    s_and_b32 s53, s52, 3
    s_lshr_b32 s54, s20, 1
    s_lshl_b32 s54, s54, 2
    s_or_b32 s53, s53, s54
    s_lshl_b32 s53, s53, 5
    v_xor_b32 v9, s53, v8
    s_lshl_b32 s54, s52, 10
    s_add_u32 m0, s56, s54
    s_add_u32 s54, s55, s54
    buffer_load_dwordx4 v9, s[24:27], s54 offen lds
    s_add_u32 s52, s52, 1
    s_cmp_lt_u32 s52, 4
    s_cbranch_scc1 K1_xl
    s_mov_b32 s57, 131072
    v_and_b32 v11, 3, v4
    v_bfe_u32 v16, v4, 3, 1
    v_lshl_add_u32 v11, v16, 2, v11
    v_lshlrev_b32 v11, 1, v11
    v_lshlrev_b32 v16, 10, v4
    v_add_u32 v16, s57, v16
    v_add_u32 v17, 0, v3
    v_xor_b32 v17, v17, v11
    v_lshl_add_u32 v56, v17, 4, v16
    v_add_u32 v17, 4, v3
    v_xor_b32 v17, v17, v11
    v_lshl_add_u32 v57, v17, 4, v16
    v_add_u32 v17, 8, v3
    v_xor_b32 v17, v17, v11
    v_lshl_add_u32 v58, v17, 4, v16
    v_add_u32 v17, 12, v3
    v_xor_b32 v17, v17, v11
    v_lshl_add_u32 v59, v17, 4, v16
    s_cmp_ge_u32 s2, 128
    s_cbranch_scc1 K1_ffn
    s_and_b32 s21, s2, 31
    s_lshr_b32 s22, s2, 5
    s_lshl_b32 s23, s22, 7
    s_lshl_b32 s3, s20, 5
    s_add_u32 s23, s23, s3
    v_add_u32 v8, s23, v4
    v_lshlrev_b32 v8, 13, v8
    v_lshl_add_u32 v8, v3, 4, v8
    s_lshl_b32 s3, s21, 8
    buffer_load_dwordx4 v[128:131], v8, s[32:35], s3 offen offset:0
    buffer_load_dwordx4 v[132:135], v8, s[32:35], s3 offen offset:64
    buffer_load_dwordx4 v[136:139], v8, s[32:35], s3 offen offset:128
    buffer_load_dwordx4 v[140:143], v8, s[32:35], s3 offen offset:192
    v_add_u32 v8, 0x20000, v8
    buffer_load_dwordx4 v[144:147], v8, s[32:35], s3 offen offset:0
    buffer_load_dwordx4 v[148:151], v8, s[32:35], s3 offen offset:64
    buffer_load_dwordx4 v[152:155], v8, s[32:35], s3 offen offset:128
    buffer_load_dwordx4 v[156:159], v8, s[32:35], s3 offen offset:192
    v_lshlrev_b32 v9, 1, v3
    v_xor_b32 v9, v9, v4
    v_lshlrev_b32 v10, 4, v9
    v_lshl_add_u32 v10, v3, 13, v10
    v_lshlrev_b32 v9, 1, v3
    v_or_b32 v9, 8, v9
    v_xor_b32 v9, v9, v4
    v_lshlrev_b32 v11, 4, v9
    v_lshl_add_u32 v11, v3, 13, v11
    s_lshl_b32 s16, s20, 20
    s_add_u32 s16, s16, s3
    s_lshl_b32 s17, s20, 15
    s_mov_b32 s52, 0
K1_ql:
    s_add_u32 m0, s17, 0
    s_add_u32 s18, s16, 0
    buffer_load_dwordx4 v10, s[28:31], s18 offen lds
    s_add_u32 m0, s17, 1024
    s_add_u32 s18, s16, 32768
    buffer_load_dwordx4 v10, s[28:31], s18 offen lds
    s_add_u32 m0, s17, 2048
    s_add_u32 s18, s16, 65536
    buffer_load_dwordx4 v11, s[28:31], s18 offen lds
    s_add_u32 m0, s17, 3072
    s_add_u32 s18, s16, 98304
    buffer_load_dwordx4 v11, s[28:31], s18 offen lds
    s_add_u32 s17, s17, 4096
    s_add_u32 s16, s16, 131072
    s_add_u32 s52, s52, 1
    s_cmp_lt_u32 s52, 8
    s_cbranch_scc1 K1_ql
    v_and_b32 v9, 1, v3
    v_lshl_add_u32 v9, v9, 2, v5
    v_lshlrev_b32 v9, 1, v9
    v_lshl_add_u32 v12, v3, 3, v5
    v_lshlrev_b32 v12, 8, v12
    v_and_b32 v13, 1, v6
    v_lshl_add_u32 v12, v13, 3, v12
    v_lshrrev_b32 v13, 1, v6
    v_lshl_add_u32 v12, v13, 4, v12
    s_lshl_b32 s3, s20, 2
    v_mov_b32 v13, s3
    v_add_u32 v13, 0, v13
    v_xor_b32 v13, v13, v9
    v_lshl_add_u32 v14, v13, 4, v12
    v_add_u32 v15, 0x10000, v14
    v_mov_b32 v13, s3
    v_add_u32 v13, 2, v13
    v_xor_b32 v13, v13, v9
    v_lshl_add_u32 v16, v13, 4, v12
    v_add_u32 v17, 0x10000, v16
    v_mov_b32 v32, 0
    v_mov_b32 v33, 0
    v_mov_b32 v34, 0
    v_mov_b32 v35, 0
    v_mov_b32 v36, 0
    v_mov_b32 v37, 0
    v_mov_b32 v38, 0
    v_mov_b32 v39, 0
    s_waitcnt vmcnt(0)
    s_barrier
    s_mov_b32 s52, 0
K1_qm:
    ds_read_b128 v[64:67], v56
    v_add_u32 v56, 256, v56
    ds_read_b64_tr_b16 v[160:161], v14 offset:0
    ds_read_b64_tr_b16 v[162:163], v14 offset:1024
    ds_read_b64_tr_b16 v[164:165], v16 offset:0
    ds_read_b64_tr_b16 v[166:167], v16 offset:1024
    ds_read_b128 v[68:71], v57
    v_add_u32 v57, 256, v57
    ds_read_b64_tr_b16 v[168:169], v14 offset:8192
    ds_read_b64_tr_b16 v[170:171], v14 offset:9216
    ds_read_b64_tr_b16 v[172:173], v16 offset:8192
    ds_read_b64_tr_b16 v[174:175], v16 offset:9216
    ds_read_b128 v[72:75], v58
    v_add_u32 v58, 256, v58
    ds_read_b64_tr_b16 v[176:177], v14 offset:16384
    ds_read_b64_tr_b16 v[178:179], v14 offset:17408
    ds_read_b64_tr_b16 v[180:181], v16 offset:16384
    ds_read_b64_tr_b16 v[182:183], v16 offset:17408
    ds_read_b128 v[76:79], v59
    v_add_u32 v59, 256, v59
    ds_read_b64_tr_b16 v[184:185], v14 offset:24576
    ds_read_b64_tr_b16 v[186:187], v14 offset:25600
    ds_read_b64_tr_b16 v[188:189], v16 offset:24576
    ds_read_b64_tr_b16 v[190:191], v16 offset:25600
    s_waitcnt lgkmcnt(15)
    v_mfma_f32_16x16x32_bf16 v[32:35], v[64:67], v[160:163], v[32:35]
    v_mfma_f32_16x16x32_bf16 v[36:39], v[64:67], v[164:167], v[36:39]
    s_waitcnt lgkmcnt(10)
    v_mfma_f32_16x16x32_bf16 v[32:35], v[68:71], v[168:171], v[32:35]
    v_mfma_f32_16x16x32_bf16 v[36:39], v[68:71], v[172:175], v[36:39]
    s_waitcnt lgkmcnt(5)
    v_mfma_f32_16x16x32_bf16 v[32:35], v[72:75], v[176:179], v[32:35]
    v_mfma_f32_16x16x32_bf16 v[36:39], v[72:75], v[180:183], v[36:39]
    s_waitcnt lgkmcnt(0)
    v_mfma_f32_16x16x32_bf16 v[32:35], v[76:79], v[184:187], v[32:35]
    v_mfma_f32_16x16x32_bf16 v[36:39], v[76:79], v[188:191], v[36:39]
    v_add_u32 v14, 0x8000, v14
    v_add_u32 v16, 0x8000, v16
    s_add_u32 s52, s52, 1
    s_cmp_lt_u32 s52, 4
    s_cbranch_scc1 K1_qm
    s_nop 7
    s_nop 7
    s_barrier
    v_lshlrev_b32 v18, 10, v3
    v_lshl_add_u32 v18, v4, 1, v18
    s_lshl_b32 s3, s20, 6
    v_add_u32 v18, s3, v18
    v_cvt_pk_bf16_f32 v19, v32, v32
    ds_write_b16 v18, v19 offset:0
    v_cvt_pk_bf16_f32 v19, v33, v33
    ds_write_b16 v18, v19 offset:256
    v_cvt_pk_bf16_f32 v19, v34, v34
    ds_write_b16 v18, v19 offset:512
    v_cvt_pk_bf16_f32 v19, v35, v35
    ds_write_b16 v18, v19 offset:768
    v_cvt_pk_bf16_f32 v19, v36, v36
    ds_write_b16 v18, v19 offset:32
    v_cvt_pk_bf16_f32 v19, v37, v37
    ds_write_b16 v18, v19 offset:288
    v_cvt_pk_bf16_f32 v19, v38, v38
    ds_write_b16 v18, v19 offset:544
    v_cvt_pk_bf16_f32 v19, v39, v39
    ds_write_b16 v18, v19 offset:800
    s_waitcnt lgkmcnt(0)
    s_barrier
    v_lshlrev_b32 v18, 8, v4
    v_lshl_add_u32 v18, v3, 4, v18
    ds_read_b128 v[64:67], v18 offset:0
    ds_read_b128 v[68:71], v18 offset:64
    ds_read_b128 v[72:75], v18 offset:128
    ds_read_b128 v[76:79], v18 offset:192
    v_mov_b32 v40, 0
    v_mov_b32 v41, 0
    v_mov_b32 v42, 0
    v_mov_b32 v43, 0
    v_mov_b32 v44, 0
    v_mov_b32 v45, 0
    v_mov_b32 v46, 0
    v_mov_b32 v47, 0
    s_waitcnt lgkmcnt(0)
    v_mfma_f32_16x16x32_bf16 v[40:43], v[64:67], v[128:131], v[40:43]
    v_mfma_f32_16x16x32_bf16 v[40:43], v[68:71], v[132:135], v[40:43]
    v_mfma_f32_16x16x32_bf16 v[40:43], v[72:75], v[136:139], v[40:43]
    v_mfma_f32_16x16x32_bf16 v[40:43], v[76:79], v[140:143], v[40:43]
    v_mfma_f32_16x16x32_bf16 v[44:47], v[64:67], v[144:147], v[44:47]
    v_mfma_f32_16x16x32_bf16 v[44:47], v[68:71], v[148:151], v[44:47]
    v_mfma_f32_16x16x32_bf16 v[44:47], v[72:75], v[152:155], v[44:47]
    v_mfma_f32_16x16x32_bf16 v[44:47], v[76:79], v[156:159], v[44:47]
    s_nop 7
    s_nop 7
    s_mov_b32 s3, 0x3e0330b7
    v_add_u32 v18, s23, v4
    v_lshlrev_b32 v18, 1, v18
    s_lshl_b32 s19, s21, 10
    v_add_u32 v18, s19, v18
    v_cmp_gt_u32 vcc, 16, v1
    s_and_saveexec_b64 s[50:51], vcc
    v_mul_f32 v19, s3, v40
    v_cvt_pk_bf16_f32 v19, v19, v19
    buffer_store_short v19, v18, s[44:47], 0 offen offset:0
    v_add_u32 v18, 0x8000, v18
    v_mul_f32 v19, s3, v41
    v_cvt_pk_bf16_f32 v19, v19, v19
    buffer_store_short v19, v18, s[44:47], 0 offen offset:0
    v_add_u32 v18, 0x8000, v18
    v_mul_f32 v19, s3, v42
    v_cvt_pk_bf16_f32 v19, v19, v19
    buffer_store_short v19, v18, s[44:47], 0 offen offset:0
    v_add_u32 v18, 0x8000, v18
    v_mul_f32 v19, s3, v43
    v_cvt_pk_bf16_f32 v19, v19, v19
    buffer_store_short v19, v18, s[44:47], 0 offen offset:0
    v_add_u32 v18, 0x8000, v18
    v_subrev_u32 v18, 0x20000, v18
    v_mul_f32 v19, s3, v44
    v_cvt_pk_bf16_f32 v19, v19, v19
    buffer_store_short v19, v18, s[44:47], 0 offen offset:32
    v_add_u32 v18, 0x8000, v18
    v_mul_f32 v19, s3, v45
    v_cvt_pk_bf16_f32 v19, v19, v19
    buffer_store_short v19, v18, s[44:47], 0 offen offset:32
    v_add_u32 v18, 0x8000, v18
    v_mul_f32 v19, s3, v46
    v_cvt_pk_bf16_f32 v19, v19, v19
    buffer_store_short v19, v18, s[44:47], 0 offen offset:32
    v_add_u32 v18, 0x8000, v18
    v_mul_f32 v19, s3, v47
    v_cvt_pk_bf16_f32 v19, v19, v19
    buffer_store_short v19, v18, s[44:47], 0 offen offset:32
    v_add_u32 v18, 0x8000, v18
    v_subrev_u32 v18, 0x20000, v18
    s_branch K1_done
K1_ffn:
    s_sub_u32 s21, s2, 128
    v_bfe_u32 v9, v1, 4, 1
    v_lshlrev_b32 v9, 1, v9
    v_and_b32 v13, 7, v1
    v_lshrrev_b32 v12, 3, v1
    s_movk_i32 s3, 3584
    v_mul_lo_u32 v12, v12, s3
    v_xor_b32 v14, v9, v13
    v_lshl_add_u32 v10, v14, 4, v12
    v_xor_b32 v14, v9, v13
    v_xor_b32 v14, 4, v14
    v_lshl_add_u32 v11, v14, 4, v12
    s_mul_i32 s16, s20, 458752
    s_lshl_b32 s3, s21, 7
    s_add_u32 s16, s16, s3
    s_lshl_b32 s17, s20, 14
    s_mov_b32 s52, 0
    s_mov_b32 s58, s16
    s_add_u32 s59, s17, 0
K1_fl0:
    s_add_u32 m0, s59, 0
    s_add_u32 s18, s58, 0
    buffer_load_dwordx4 v10, s[36:39], s18 offen lds
    s_add_u32 m0, s59, 1024
    s_add_u32 s18, s58, 28672
    buffer_load_dwordx4 v11, s[36:39], s18 offen lds
    s_add_u32 s59, s59, 2048
    s_add_u32 s58, s58, 57344
    s_add_u32 s52, s52, 1
    s_cmp_lt_u32 s52, 8
    s_cbranch_scc1 K1_fl0
    s_mov_b32 s52, 0
    s_mov_b32 s58, s16
    s_add_u32 s59, s17, 65536
K1_fl1:
    s_add_u32 m0, s59, 0
    s_add_u32 s18, s58, 0
    buffer_load_dwordx4 v10, s[40:43], s18 offen lds
    s_add_u32 m0, s59, 1024
    s_add_u32 s18, s58, 28672
    buffer_load_dwordx4 v11, s[40:43], s18 offen lds
    s_add_u32 s59, s59, 2048
    s_add_u32 s58, s58, 57344
    s_add_u32 s52, s52, 1
    s_cmp_lt_u32 s52, 8
    s_cbranch_scc1 K1_fl1
    v_lshrrev_b32 v9, 1, v5
    v_and_b32 v13, 1, v3
    v_lshl_add_u32 v9, v13, 1, v9
    v_lshlrev_b32 v9, 1, v9
    v_lshl_add_u32 v12, v3, 3, v5
    v_lshlrev_b32 v12, 7, v12
    v_and_b32 v13, 1, v6
    v_lshl_add_u32 v12, v13, 3, v12
    v_lshrrev_b32 v13, 1, v6
    v_lshl_add_u32 v12, v13, 4, v12
    s_lshl_b32 s3, s20, 1
    v_xor_b32 v13, s3, v9
    v_lshl_add_u32 v14, v13, 4, v12
    v_add_u32 v15, 0x10000, v14
    v_mov_b32 v32, 0
    v_mov_b32 v33, 0
    v_mov_b32 v34, 0
    v_mov_b32 v35, 0
    v_mov_b32 v36, 0
    v_mov_b32 v37, 0
    v_mov_b32 v38, 0
    v_mov_b32 v39, 0
    s_waitcnt vmcnt(0)
    s_barrier
    s_mov_b32 s52, 0
K1_fm:
    ds_read_b128 v[64:67], v56
    v_add_u32 v56, 256, v56
    ds_read_b64_tr_b16 v[160:161], v14 offset:0
    ds_read_b64_tr_b16 v[162:163], v14 offset:512
    ds_read_b64_tr_b16 v[164:165], v15 offset:0
    ds_read_b64_tr_b16 v[166:167], v15 offset:512
    ds_read_b128 v[68:71], v57
    v_add_u32 v57, 256, v57
    ds_read_b64_tr_b16 v[168:169], v14 offset:4096
    ds_read_b64_tr_b16 v[170:171], v14 offset:4608
    ds_read_b64_tr_b16 v[172:173], v15 offset:4096
    ds_read_b64_tr_b16 v[174:175], v15 offset:4608
    ds_read_b128 v[72:75], v58
    v_add_u32 v58, 256, v58
    ds_read_b64_tr_b16 v[176:177], v14 offset:8192
    ds_read_b64_tr_b16 v[178:179], v14 offset:8704
    ds_read_b64_tr_b16 v[180:181], v15 offset:8192
    ds_read_b64_tr_b16 v[182:183], v15 offset:8704
    ds_read_b128 v[76:79], v59
    v_add_u32 v59, 256, v59
    ds_read_b64_tr_b16 v[184:185], v14 offset:12288
    ds_read_b64_tr_b16 v[186:187], v14 offset:12800
    ds_read_b64_tr_b16 v[188:189], v15 offset:12288
    ds_read_b64_tr_b16 v[190:191], v15 offset:12800
    s_waitcnt lgkmcnt(15)
    v_mfma_f32_16x16x32_bf16 v[32:35], v[64:67], v[160:163], v[32:35]
    v_mfma_f32_16x16x32_bf16 v[36:39], v[64:67], v[164:167], v[36:39]
    s_waitcnt lgkmcnt(10)
    v_mfma_f32_16x16x32_bf16 v[32:35], v[68:71], v[168:171], v[32:35]
    v_mfma_f32_16x16x32_bf16 v[36:39], v[68:71], v[172:175], v[36:39]
    s_waitcnt lgkmcnt(5)
    v_mfma_f32_16x16x32_bf16 v[32:35], v[72:75], v[176:179], v[32:35]
    v_mfma_f32_16x16x32_bf16 v[36:39], v[72:75], v[180:183], v[36:39]
    s_waitcnt lgkmcnt(0)
    v_mfma_f32_16x16x32_bf16 v[32:35], v[76:79], v[184:187], v[32:35]
    v_mfma_f32_16x16x32_bf16 v[36:39], v[76:79], v[188:191], v[36:39]
    v_add_u32 v14, 0x4000, v14
    v_add_u32 v15, 0x4000, v15
    s_add_u32 s52, s52, 1
    s_cmp_lt_u32 s52, 4
    s_cbranch_scc1 K1_fm
    s_nop 7
    s_nop 7
    s_lshl_b32 s3, s21, 6
    s_lshl_b32 s19, s20, 4
    s_add_u32 s3, s3, s19
    v_add_u32 v18, s3, v4
    v_lshlrev_b32 v18, 1, v18
    v_add_u32 v18, 131072, v18
    v_cmp_gt_u32 vcc, 16, v1
    s_and_saveexec_b64 s[50:51], vcc
    v_max_f32 v19, 0, v32
    v_mul_f32 v19, v19, v36
    v_cvt_pk_bf16_f32 v19, v19, v19
    buffer_store_short v19, v18, s[44:47], 0 offen
    v_add_u32 v18, 3584, v18
    v_max_f32 v19, 0, v33
    v_mul_f32 v19, v19, v37
    v_cvt_pk_bf16_f32 v19, v19, v19
    buffer_store_short v19, v18, s[44:47], 0 offen
    v_add_u32 v18, 3584, v18
    v_max_f32 v19, 0, v34
    v_mul_f32 v19, v19, v38
    v_cvt_pk_bf16_f32 v19, v19, v19
    buffer_store_short v19, v18, s[44:47], 0 offen
    v_add_u32 v18, 3584, v18
    v_max_f32 v19, 0, v35
    v_mul_f32 v19, v19, v39
    v_cvt_pk_bf16_f32 v19, v19, v19
    buffer_store_short v19, v18, s[44:47], 0 offen
    v_add_u32 v18, 3584, v18
K1_done:
    s_endpgm
.globl k2_attn_kernel
.p2align 8
.type k2_attn_kernel,@function
k2_attn_kernel:
    s_cmp_ge_u32 s2, 256
    s_cbranch_scc1 K2_done
    s_load_dwordx2 s[4:5], s[0:1], 8
    s_load_dwordx2 s[14:15], s[0:1], 104
    v_and_b32 v1, 63, v0
    v_lshrrev_b32 v2, 6, v0
    v_lshrrev_b32 v3, 4, v1
    v_and_b32 v4, 15, v1
    v_lshrrev_b32 v5, 2, v4
    v_and_b32 v6, 3, v4
    v_readfirstlane_b32 s20, v2
    s_waitcnt lgkmcnt(0)
    s_mov_b32 s24, s4
    s_and_b32 s25, s5, 0xffff
    s_mov_b32 s26, 16777216
    s_mov_b32 s27, 0x00020000
    s_mov_b32 s44, s14
    s_and_b32 s45, s15, 0xffff
    s_mov_b32 s46, 20971520
    s_mov_b32 s47, 0x00020000
    s_lshr_b32 s21, s2, 7
    s_and_b32 s22, s2, 127
    s_lshr_b32 s23, s22, 5
    s_lshl_b32 s3, s23, 15
    s_lshl_b32 s19, s21, 14
    s_add_u32 s3, s3, s19
    v_lshlrev_b32 v8, 4, v1
    s_lshl_b32 s55, s20, 12
    s_add_u32 s56, s55, 139264
    s_add_u32 s55, s55, s3
    s_mov_b32 s52, 0
K2_ql:
    s_and_b32 s53, s52, 3
    s_lshr_b32 s54, s20, 1
    s_lshl_b32 s54, s54, 2
    s_or_b32 s53, s53, s54
    s_lshl_b32 s53, s53, 5
    v_xor_b32 v9, s53, v8
    s_lshl_b32 s54, s52, 10
    s_add_u32 m0, s56, s54
    s_add_u32 s54, s55, s54
    buffer_load_dwordx4 v9, s[44:47], s54 offen lds
    s_add_u32 s52, s52, 1
    s_cmp_lt_u32 s52, 4
    s_cbranch_scc1 K2_ql
    s_mov_b32 s57, 139264
    v_and_b32 v11, 3, v4
    v_bfe_u32 v16, v4, 3, 1
    v_lshl_add_u32 v11, v16, 2, v11
    v_lshlrev_b32 v11, 1, v11
    v_lshlrev_b32 v16, 10, v4
    v_add_u32 v16, s57, v16
    v_add_u32 v17, 0, v3
    v_xor_b32 v17, v17, v11
    v_lshl_add_u32 v56, v17, 4, v16
    v_add_u32 v17, 4, v3
    v_xor_b32 v17, v17, v11
    v_lshl_add_u32 v57, v17, 4, v16
    v_add_u32 v17, 8, v3
    v_xor_b32 v17, v17, v11
    v_lshl_add_u32 v58, v17, 4, v16
    v_add_u32 v17, 12, v3
    v_xor_b32 v17, v17, v11
    v_lshl_add_u32 v59, v17, 4, v16
    s_lshl_b32 s16, s22, 17
    s_lshl_b32 s3, s20, 15
    s_add_u32 s16, s16, s3
    s_add_u32 s17, s3, 8192
    v_lshlrev_b32 v8, 4, v1
    s_mov_b32 s52, 0
K2_cl:
    s_and_b32 s53, s52, 3
    s_bfe_u32 s54, s52, 0x10003
    s_lshl_b32 s54, s54, 2
    s_or_b32 s53, s53, s54
    s_lshl_b32 s53, s53, 5
    v_xor_b32 v9, s53, v8
    s_lshl_b32 s54, s52, 10
    s_add_u32 m0, s17, s54
    s_add_u32 s54, s16, s54
    buffer_load_dwordx4 v9, s[24:27], s54 offen lds
    s_add_u32 s52, s52, 1
    s_cmp_lt_u32 s52, 32
    s_cbranch_scc1 K2_cl
    v_and_b32 v11, 3, v4
    v_bfe_u32 v16, v4, 3, 1
    v_lshl_add_u32 v11, v16, 2, v11
    v_lshlrev_b32 v11, 1, v11
    v_lshlrev_b32 v16, 10, v4
    v_add_u32 v16, s17, v16
    v_add_u32 v17, 0, v3
    v_xor_b32 v17, v17, v11
    v_lshl_add_u32 v12, v17, 4, v16
    v_add_u32 v17, 4, v3
    v_xor_b32 v17, v17, v11
    v_lshl_add_u32 v13, v17, 4, v16
    v_add_u32 v17, 8, v3
    v_xor_b32 v17, v17, v11
    v_lshl_add_u32 v14, v17, 4, v16
    v_add_u32 v17, 12, v3
    v_xor_b32 v17, v17, v11
    v_lshl_add_u32 v15, v17, 4, v16
    v_mov_b32 v32, 0
    v_mov_b32 v33, 0
    v_mov_b32 v34, 0
    v_mov_b32 v35, 0
    v_mov_b32 v36, 0
    v_mov_b32 v37, 0
    v_mov_b32 v38, 0
    v_mov_b32 v39, 0
    s_waitcnt vmcnt(0)
    s_barrier
    s_mov_b32 s52, 0
K2_qk:
    ds_read_b128 v[64:67], v56
    v_add_u32 v56, 256, v56
    ds_read_b128 v[160:163], v12 offset:0
    ds_read_b128 v[164:167], v12 offset:16384
    v_add_u32 v12, 256, v12
    ds_read_b128 v[68:71], v57
    v_add_u32 v57, 256, v57
    ds_read_b128 v[168:171], v13 offset:0
    ds_read_b128 v[172:175], v13 offset:16384
    v_add_u32 v13, 256, v13
    ds_read_b128 v[72:75], v58
    v_add_u32 v58, 256, v58
    ds_read_b128 v[176:179], v14 offset:0
    ds_read_b128 v[180:183], v14 offset:16384
    v_add_u32 v14, 256, v14
    ds_read_b128 v[76:79], v59
    v_add_u32 v59, 256, v59
    ds_read_b128 v[184:187], v15 offset:0
    ds_read_b128 v[188:191], v15 offset:16384
    v_add_u32 v15, 256, v15
    s_waitcnt lgkmcnt(9)
    v_mfma_f32_16x16x32_bf16 v[32:35], v[160:163], v[64:67], v[32:35]
    v_mfma_f32_16x16x32_bf16 v[36:39], v[164:167], v[64:67], v[36:39]
    s_waitcnt lgkmcnt(6)
    v_mfma_f32_16x16x32_bf16 v[32:35], v[168:171], v[68:71], v[32:35]
    v_mfma_f32_16x16x32_bf16 v[36:39], v[172:175], v[68:71], v[36:39]
    s_waitcnt lgkmcnt(3)
    v_mfma_f32_16x16x32_bf16 v[32:35], v[176:179], v[72:75], v[32:35]
    v_mfma_f32_16x16x32_bf16 v[36:39], v[180:183], v[72:75], v[36:39]
    s_waitcnt lgkmcnt(0)
    v_mfma_f32_16x16x32_bf16 v[32:35], v[184:187], v[76:79], v[32:35]
    v_mfma_f32_16x16x32_bf16 v[36:39], v[188:191], v[76:79], v[36:39]
    s_add_u32 s52, s52, 1
    s_cmp_lt_u32 s52, 4
    s_cbranch_scc1 K2_qk
    s_nop 7
    s_nop 7
    v_max3_f32 v20, v32, v33, v34
    v_max3_f32 v20, v20, v35, v36
    v_max3_f32 v20, v20, v37, v38
    v_max_f32 v20, v20, v39
    v_xor_b32 v21, 16, v1
    v_lshlrev_b32 v21, 2, v21
    v_xor_b32 v22, 32, v1
    v_lshlrev_b32 v22, 2, v22
    ds_bpermute_b32 v23, v21, v20
    s_waitcnt lgkmcnt(0)
    v_max_f32 v20, v20, v23
    ds_bpermute_b32 v23, v22, v20
    s_waitcnt lgkmcnt(0)
    v_max_f32 v20, v20, v23
    s_lshl_b32 s3, s20, 6
    v_lshlrev_b32 v24, 2, v4
    v_add_u32 v25, s3, v24
    ds_write_b32 v25, v20 offset:4352
    s_waitcnt lgkmcnt(0)
    s_barrier
    ds_read_b32 v26, v24 offset:4352
    ds_read_b32 v27, v24 offset:4416
    ds_read_b32 v28, v24 offset:4480
    ds_read_b32 v29, v24 offset:4544
    s_waitcnt lgkmcnt(0)
    v_max3_f32 v20, v26, v27, v28
    v_max_f32 v20, v20, v29
    v_sub_f32 v32, v32, v20
    v_exp_f32 v32, v32
    v_sub_f32 v33, v33, v20
    v_exp_f32 v33, v33
    v_sub_f32 v34, v34, v20
    v_exp_f32 v34, v34
    v_sub_f32 v35, v35, v20
    v_exp_f32 v35, v35
    v_sub_f32 v36, v36, v20
    v_exp_f32 v36, v36
    v_sub_f32 v37, v37, v20
    v_exp_f32 v37, v37
    v_sub_f32 v38, v38, v20
    v_exp_f32 v38, v38
    v_sub_f32 v39, v39, v20
    v_exp_f32 v39, v39
    s_nop 0
    s_lshl_b32 s3, s20, 6
    v_mul_u32_u24 v25, 272, v4
    v_lshl_add_u32 v25, v3, 3, v25
    v_add_u32 v25, s3, v25
    v_mov_b32 v30, 0
    v_cvt_pk_bf16_f32 v40, v32, v33
    v_cvt_pk_bf16_f32 v41, v34, v35
    ds_write_b64 v25, v[40:41] offset:0
    v_lshlrev_b32 v31, 16, v40
    v_add_f32 v30, v30, v31
    v_and_b32 v31, 0xffff0000, v40
    v_add_f32 v30, v30, v31
    v_lshlrev_b32 v31, 16, v41
    v_add_f32 v30, v30, v31
    v_and_b32 v31, 0xffff0000, v41
    v_add_f32 v30, v30, v31
    v_cvt_pk_bf16_f32 v40, v36, v37
    v_cvt_pk_bf16_f32 v41, v38, v39
    ds_write_b64 v25, v[40:41] offset:32
    v_lshlrev_b32 v31, 16, v40
    v_add_f32 v30, v30, v31
    v_and_b32 v31, 0xffff0000, v40
    v_add_f32 v30, v30, v31
    v_lshlrev_b32 v31, 16, v41
    v_add_f32 v30, v30, v31
    v_and_b32 v31, 0xffff0000, v41
    v_add_f32 v30, v30, v31
    ds_bpermute_b32 v23, v21, v30
    s_waitcnt lgkmcnt(0)
    v_add_f32 v30, v30, v23
    ds_bpermute_b32 v23, v22, v30
    s_waitcnt lgkmcnt(0)
    v_add_f32 v30, v30, v23
    s_lshl_b32 s3, s20, 6
    v_add_u32 v31, s3, v24
    ds_write_b32 v31, v30 offset:4608
    s_waitcnt lgkmcnt(0)
    s_barrier
    ds_read_b32 v26, v24 offset:4608
    ds_read_b32 v27, v24 offset:4672
    ds_read_b32 v28, v24 offset:4736
    ds_read_b32 v29, v24 offset:4800
    v_mul_u32_u24 v25, 272, v4
    v_lshl_add_u32 v25, v3, 4, v25
    ds_read_b128 v[128:131], v25 offset:0
    ds_read_b128 v[132:135], v25 offset:64
    ds_read_b128 v[136:139], v25 offset:128
    ds_read_b128 v[140:143], v25 offset:192
    v_and_b32 v9, 1, v3
    v_lshl_add_u32 v9, v9, 2, v5
    v_lshlrev_b32 v9, 1, v9
    v_lshl_add_u32 v10, v3, 3, v5
    v_lshlrev_b32 v10, 10, v10
    v_and_b32 v11, 1, v6
    v_lshl_add_u32 v10, v11, 3, v10
    v_lshrrev_b32 v11, 1, v6
    v_lshl_add_u32 v10, v11, 4, v10
    s_lshl_b32 s3, s20, 8
    v_add_u32 v10, s3, v10
    s_waitcnt lgkmcnt(0)
    v_add_f32 v30, v26, v27
    v_add_f32 v31, v28, v29
    v_add_f32 v21, v30, v31
    s_lshl_b32 s3, s22, 5
    s_lshl_b32 s19, s21, 4
    s_add_u32 s3, s3, s19
    v_add_u32 v22, s3, v4
    v_lshlrev_b32 v23, 3, v22
    v_add_u32 v23, 163840, v23
    v_lshlrev_b32 v22, 11, v22
    v_lshl_add_u32 v22, v3, 4, v22
    s_lshl_b32 s3, s20, 9
    v_add_u32 v22, s3, v22
    v_add_u32 v22, 1048576, v22
    v_cmp_gt_u32 vcc, 16, v0
    s_and_saveexec_b64 s[50:51], vcc
    buffer_store_dwordx2 v[20:21], v23, s[44:47], 0 offen
    s_mov_b64 exec, s[50:51]
    s_mov_b32 s52, 0
K2_pv:
    v_xor_b32 v11, s52, v9
    v_lshl_add_u32 v12, v11, 4, v10
    v_add_u32 v13, 0x10000, v12
    v_mov_b32 v48, 0
    v_mov_b32 v49, 0
    v_mov_b32 v50, 0
    v_mov_b32 v51, 0
    ds_read_b64_tr_b16 v[160:161], v12 offset:8192
    ds_read_b64_tr_b16 v[162:163], v12 offset:12288
    ds_read_b64_tr_b16 v[164:165], v12 offset:40960
    ds_read_b64_tr_b16 v[166:167], v12 offset:45056
    ds_read_b64_tr_b16 v[168:169], v13 offset:8192
    ds_read_b64_tr_b16 v[170:171], v13 offset:12288
    ds_read_b64_tr_b16 v[172:173], v13 offset:40960
    ds_read_b64_tr_b16 v[174:175], v13 offset:45056
    s_waitcnt lgkmcnt(0)
    v_mfma_f32_16x16x32_bf16 v[48:51], v[160:163], v[128:131], v[48:51]
    v_mfma_f32_16x16x32_bf16 v[48:51], v[164:167], v[132:135], v[48:51]
    v_mfma_f32_16x16x32_bf16 v[48:51], v[168:171], v[136:139], v[48:51]
    v_mfma_f32_16x16x32_bf16 v[48:51], v[172:175], v[140:143], v[48:51]
    s_nop 7
    s_nop 1
    buffer_store_dwordx4 v[48:51], v22, s[44:47], 0 offen offset:0
    s_nop 1
    v_add_u32 v22, 64, v22
    s_add_u32 s52, s52, 2
    s_cmp_lt_u32 s52, 16
    s_cbranch_scc1 K2_pv
K2_done:
    s_endpgm
.globl k3_proj_kernel
.p2align 8
.type k3_proj_kernel,@function
k3_proj_kernel:
    s_cmp_ge_u32 s2, 256
    s_cbranch_scc1 K3_done
    s_load_dwordx2 s[4:5], s[0:1], 32
    s_load_dwordx2 s[6:7], s[0:1], 40
    s_load_dwordx2 s[8:9], s[0:1], 72
    s_load_dwordx2 s[10:11], s[0:1], 0
    s_load_dwordx2 s[12:13], s[0:1], 80
    s_load_dwordx2 s[14:15], s[0:1], 104
    v_and_b32 v1, 63, v0
    v_lshrrev_b32 v2, 6, v0
    v_lshrrev_b32 v3, 4, v1
    v_and_b32 v4, 15, v1
    v_lshrrev_b32 v5, 2, v4
    v_and_b32 v6, 3, v4
    v_readfirstlane_b32 s20, v2
    s_waitcnt lgkmcnt(0)
    s_mov_b32 s24, s4
    s_and_b32 s25, s5, 0xffff
    s_mov_b32 s26, 4194304
    s_mov_b32 s27, 0x00020000
    s_mov_b32 s28, s6
    s_and_b32 s29, s7, 0xffff
    s_mov_b32 s30, 4194304
    s_mov_b32 s31, 0x00020000
    s_mov_b32 s32, s8
    s_and_b32 s33, s9, 0xffff
    s_mov_b32 s34, 1835008
    s_mov_b32 s35, 0x00020000
    s_mov_b32 s36, s10
    s_and_b32 s37, s11, 0xffff
    s_mov_b32 s38, 4096
    s_mov_b32 s39, 0x00020000
    s_mov_b32 s40, s12
    s_and_b32 s41, s13, 0xffff
    s_mov_b32 s42, 1024
    s_mov_b32 s43, 0x00020000
    s_mov_b32 s44, s14
    s_and_b32 s45, s15, 0xffff
    s_mov_b32 s46, 20971520
    s_mov_b32 s47, 0x00020000
    s_and_b32 s21, s2, 31
    s_lshr_b32 s22, s2, 5
    s_lshl_b32 s3, s20, 5
    v_lshl_add_u32 v7, v3, 3, s3
    v_lshlrev_b32 v7, 5, v7
    v_add_u32 v7, s21, v7
    v_lshlrev_b32 v8, 3, v7
    v_add_u32 v8, 163840, v8
    v_lshlrev_b32 v7, 11, v7
    v_lshl_add_u32 v7, v4, 4, v7
    s_lshl_b32 s3, s22, 8
    s_add_u32 s3, s3, 1048576
    buffer_load_dwordx4 v[64:67], v7, s[44:47], s3 offen
    v_add_u32 v7, 0x10000, v7
    buffer_load_dwordx4 v[68:71], v7, s[44:47], s3 offen
    v_add_u32 v7, 0x10000, v7
    buffer_load_dwordx4 v[72:75], v7, s[44:47], s3 offen
    v_add_u32 v7, 0x10000, v7
    buffer_load_dwordx4 v[76:79], v7, s[44:47], s3 offen
    v_add_u32 v7, 0x10000, v7
    buffer_load_dwordx4 v[80:83], v7, s[44:47], s3 offen
    v_add_u32 v7, 0x10000, v7
    buffer_load_dwordx4 v[84:87], v7, s[44:47], s3 offen
    v_add_u32 v7, 0x10000, v7
    buffer_load_dwordx4 v[88:91], v7, s[44:47], s3 offen
    v_add_u32 v7, 0x10000, v7
    buffer_load_dwordx4 v[92:95], v7, s[44:47], s3 offen
    v_add_u32 v7, 0x10000, v7
    buffer_load_dwordx2 v[96:97], v8, s[44:47], 0 offen offset:0
    buffer_load_dwordx2 v[98:99], v8, s[44:47], 0 offen offset:256
    buffer_load_dwordx2 v[100:101], v8, s[44:47], 0 offen offset:512
    buffer_load_dwordx2 v[102:103], v8, s[44:47], 0 offen offset:768
    buffer_load_dwordx2 v[104:105], v8, s[44:47], 0 offen offset:1024
    buffer_load_dwordx2 v[106:107], v8, s[44:47], 0 offen offset:1280
    buffer_load_dwordx2 v[108:109], v8, s[44:47], 0 offen offset:1536
    buffer_load_dwordx2 v[110:111], v8, s[44:47], 0 offen offset:1792
    v_lshlrev_b32 v9, 4, v1
    s_lshl_b32 s3, s20, 10
    buffer_load_dwordx4 v[112:115], v9, s[36:39], s3 offen
    buffer_load_dwordx4 v[116:119], v9, s[40:43], 0 offen
    v_lshlrev_b32 v13, 1, v3
    v_xor_b32 v13, v13, v4
    v_lshlrev_b32 v10, 4, v13
    v_lshl_add_u32 v10, v3, 13, v10
    v_lshlrev_b32 v13, 1, v3
    v_or_b32 v13, 8, v13
    v_xor_b32 v13, v13, v4
    v_lshlrev_b32 v11, 4, v13
    v_lshl_add_u32 v11, v3, 13, v11
    s_lshl_b32 s16, s22, 19
    s_lshl_b32 s3, s21, 8
    s_add_u32 s16, s16, s3
    s_lshl_b32 s3, s20, 17
    s_add_u32 s16, s16, s3
    s_lshl_b32 s17, s20, 12
    s_add_u32 m0, s17, 16384
    s_add_u32 s18, s16, 0
    buffer_load_dwordx4 v10, s[24:27], s18 offen lds
    s_add_u32 m0, s17, 17408
    s_add_u32 s18, s16, 32768
    buffer_load_dwordx4 v10, s[24:27], s18 offen lds
    s_add_u32 m0, s17, 18432
    s_add_u32 s18, s16, 65536
    buffer_load_dwordx4 v11, s[24:27], s18 offen lds
    s_add_u32 m0, s17, 19456
    s_add_u32 s18, s16, 98304
    buffer_load_dwordx4 v11, s[24:27], s18 offen lds
    s_lshl_b32 s16, s21, 17
    s_lshl_b32 s3, s20, 15
    s_add_u32 s16, s16, s3
    s_add_u32 s17, s3, 32768
    v_lshlrev_b32 v12, 4, v1
    v_lshlrev_b32 v8, 4, v1
    s_mov_b32 s52, 0
K3_ol:
    s_and_b32 s53, s52, 3
    s_bfe_u32 s54, s52, 0x10003
    s_lshl_b32 s54, s54, 2
    s_or_b32 s53, s53, s54
    s_lshl_b32 s53, s53, 5
    v_xor_b32 v9, s53, v8
    s_lshl_b32 s54, s52, 10
    s_add_u32 m0, s17, s54
    s_add_u32 s54, s16, s54
    buffer_load_dwordx4 v9, s[28:31], s54 offen lds
    s_add_u32 s52, s52, 1
    s_cmp_lt_u32 s52, 32
    s_cbranch_scc1 K3_ol
    s_cmp_lg_u32 s20, 0
    s_cbranch_scc1 K3_nowd
    s_mul_i32 s16, s2, 7168
    v_xor_b32 v13, 0, v12
    s_mov_b32 m0, 8192
    s_add_u32 s18, s16, 0
    buffer_load_dwordx4 v13, s[32:35], s18 offen lds
    v_xor_b32 v14, 32, v12
    s_mov_b32 m0, 9216
    s_add_u32 s18, s16, 1024
    buffer_load_dwordx4 v14, s[32:35], s18 offen lds
    v_xor_b32 v13, 64, v12
    s_mov_b32 m0, 10240
    s_add_u32 s18, s16, 2048
    buffer_load_dwordx4 v13, s[32:35], s18 offen lds
    v_xor_b32 v14, 96, v12
    s_mov_b32 m0, 11264
    s_add_u32 s18, s16, 3072
    buffer_load_dwordx4 v14, s[32:35], s18 offen lds
    v_xor_b32 v13, 0, v12
    s_mov_b32 m0, 12288
    s_add_u32 s18, s16, 4096
    buffer_load_dwordx4 v13, s[32:35], s18 offen lds
    v_xor_b32 v14, 32, v12
    s_mov_b32 m0, 13312
    s_add_u32 s18, s16, 5120
    buffer_load_dwordx4 v14, s[32:35], s18 offen lds
    v_xor_b32 v13, 64, v12
    s_mov_b32 m0, 14336
    s_add_u32 s18, s16, 6144
    buffer_load_dwordx4 v13, s[32:35], s18 offen lds
    v_xor_b32 v14, 96, v12
    s_mov_b32 m0, 15360
    s_add_u32 s18, s16, 6144
    buffer_load_dwordx4 v14, s[32:35], s18 offen lds
K3_nowd:
    s_waitcnt vmcnt(36)
    v_max3_f32 v20, v96, v98, v100
    v_max3_f32 v20, v20, v102, v104
    v_max3_f32 v20, v20, v106, v108
    v_max_f32 v20, v20, v110
    v_xor_b32 v21, 16, v1
    v_lshlrev_b32 v21, 2, v21
    v_xor_b32 v22, 32, v1
    v_lshlrev_b32 v22, 2, v22
    ds_bpermute_b32 v23, v21, v20
    s_waitcnt lgkmcnt(0)
    v_max_f32 v20, v20, v23
    ds_bpermute_b32 v23, v22, v20
    s_waitcnt lgkmcnt(0)
    v_max_f32 v20, v20, v23
    v_mov_b32 v24, 0
    v_mov_b32 v26, 0
    v_mov_b32 v27, 0
    v_mov_b32 v28, 0
    v_mov_b32 v29, 0
    v_sub_f32 v25, v96, v20
    v_exp_f32 v25, v25
    s_nop 0
    v_fmac_f32 v24, v25, v97
    v_fmac_f32 v26, v25, v64
    v_fmac_f32 v27, v25, v65
    v_fmac_f32 v28, v25, v66
    v_fmac_f32 v29, v25, v67
    v_sub_f32 v25, v98, v20
    v_exp_f32 v25, v25
    s_nop 0
    v_fmac_f32 v24, v25, v99
    v_fmac_f32 v26, v25, v68
    v_fmac_f32 v27, v25, v69
    v_fmac_f32 v28, v25, v70
    v_fmac_f32 v29, v25, v71
    v_sub_f32 v25, v100, v20
    v_exp_f32 v25, v25
    s_nop 0
    v_fmac_f32 v24, v25, v101
    v_fmac_f32 v26, v25, v72
    v_fmac_f32 v27, v25, v73
    v_fmac_f32 v28, v25, v74
    v_fmac_f32 v29, v25, v75
    v_sub_f32 v25, v102, v20
    v_exp_f32 v25, v25
    s_nop 0
    v_fmac_f32 v24, v25, v103
    v_fmac_f32 v26, v25, v76
    v_fmac_f32 v27, v25, v77
    v_fmac_f32 v28, v25, v78
    v_fmac_f32 v29, v25, v79
    v_sub_f32 v25, v104, v20
    v_exp_f32 v25, v25
    s_nop 0
    v_fmac_f32 v24, v25, v105
    v_fmac_f32 v26, v25, v80
    v_fmac_f32 v27, v25, v81
    v_fmac_f32 v28, v25, v82
    v_fmac_f32 v29, v25, v83
    v_sub_f32 v25, v106, v20
    v_exp_f32 v25, v25
    s_nop 0
    v_fmac_f32 v24, v25, v107
    v_fmac_f32 v26, v25, v84
    v_fmac_f32 v27, v25, v85
    v_fmac_f32 v28, v25, v86
    v_fmac_f32 v29, v25, v87
    v_sub_f32 v25, v108, v20
    v_exp_f32 v25, v25
    s_nop 0
    v_fmac_f32 v24, v25, v109
    v_fmac_f32 v26, v25, v88
    v_fmac_f32 v27, v25, v89
    v_fmac_f32 v28, v25, v90
    v_fmac_f32 v29, v25, v91
    v_sub_f32 v25, v110, v20
    v_exp_f32 v25, v25
    s_nop 0
    v_fmac_f32 v24, v25, v111
    v_fmac_f32 v26, v25, v92
    v_fmac_f32 v27, v25, v93
    v_fmac_f32 v28, v25, v94
    v_fmac_f32 v29, v25, v95
    ds_bpermute_b32 v23, v21, v24
    s_waitcnt lgkmcnt(0)
    v_add_f32 v24, v24, v23
    ds_bpermute_b32 v23, v22, v24
    s_waitcnt lgkmcnt(0)
    v_add_f32 v24, v24, v23
    ds_bpermute_b32 v23, v21, v26
    s_waitcnt lgkmcnt(0)
    v_add_f32 v26, v26, v23
    ds_bpermute_b32 v23, v22, v26
    s_waitcnt lgkmcnt(0)
    v_add_f32 v26, v26, v23
    ds_bpermute_b32 v23, v21, v27
    s_waitcnt lgkmcnt(0)
    v_add_f32 v27, v27, v23
    ds_bpermute_b32 v23, v22, v27
    s_waitcnt lgkmcnt(0)
    v_add_f32 v27, v27, v23
    ds_bpermute_b32 v23, v21, v28
    s_waitcnt lgkmcnt(0)
    v_add_f32 v28, v28, v23
    ds_bpermute_b32 v23, v22, v28
    s_waitcnt lgkmcnt(0)
    v_add_f32 v28, v28, v23
    ds_bpermute_b32 v23, v21, v29
    s_waitcnt lgkmcnt(0)
    v_add_f32 v29, v29, v23
    ds_bpermute_b32 v23, v22, v29
    s_waitcnt lgkmcnt(0)
    v_add_f32 v29, v29, v23
    v_mov_b32 v30, 0
    v_lshlrev_b32 v31, 16, v112
    v_lshlrev_b32 v25, 16, v116
    v_fmac_f32 v30, v31, v25
    v_and_b32 v31, 0xffff0000, v112
    v_and_b32 v25, 0xffff0000, v116
    v_fmac_f32 v30, v31, v25
    v_lshlrev_b32 v31, 16, v113
    v_lshlrev_b32 v25, 16, v117
    v_fmac_f32 v30, v31, v25
    v_and_b32 v31, 0xffff0000, v113
    v_and_b32 v25, 0xffff0000, v117
    v_fmac_f32 v30, v31, v25
    v_lshlrev_b32 v31, 16, v114
    v_lshlrev_b32 v25, 16, v118
    v_fmac_f32 v30, v31, v25
    v_and_b32 v31, 0xffff0000, v114
    v_and_b32 v25, 0xffff0000, v118
    v_fmac_f32 v30, v31, v25
    v_lshlrev_b32 v31, 16, v115
    v_lshlrev_b32 v25, 16, v119
    v_fmac_f32 v30, v31, v25
    v_and_b32 v31, 0xffff0000, v115
    v_and_b32 v25, 0xffff0000, v119
    v_fmac_f32 v30, v31, v25
    v_xor_b32 v25, 1, v1
    v_lshlrev_b32 v25, 2, v25
    ds_bpermute_b32 v23, v25, v30
    s_waitcnt lgkmcnt(0)
    v_add_f32 v30, v30, v23
    v_xor_b32 v25, 2, v1
    v_lshlrev_b32 v25, 2, v25
    ds_bpermute_b32 v23, v25, v30
    s_waitcnt lgkmcnt(0)
    v_add_f32 v30, v30, v23
    v_xor_b32 v25, 4, v1
    v_lshlrev_b32 v25, 2, v25
    ds_bpermute_b32 v23, v25, v30
    s_waitcnt lgkmcnt(0)
    v_add_f32 v30, v30, v23
    v_xor_b32 v25, 8, v1
    v_lshlrev_b32 v25, 2, v25
    ds_bpermute_b32 v23, v25, v30
    s_waitcnt lgkmcnt(0)
    v_add_f32 v30, v30, v23
    v_xor_b32 v25, 16, v1
    v_lshlrev_b32 v25, 2, v25
    ds_bpermute_b32 v23, v25, v30
    s_waitcnt lgkmcnt(0)
    v_add_f32 v30, v30, v23
    v_xor_b32 v25, 32, v1
    v_lshlrev_b32 v25, 2, v25
    ds_bpermute_b32 v23, v25, v30
    s_waitcnt lgkmcnt(0)
    v_add_f32 v30, v30, v23
    v_mul_f32 v30, 0xbfb8aa3b, v30
    v_exp_f32 v30, v30
    s_nop 0
    v_add_f32 v30, 1.0, v30
    v_rcp_f32 v30, v30
    s_nop 0
    v_rcp_f32 v24, v24
    s_nop 0
    v_mul_f32 v24, v24, v30
    v_mul_f32 v26, v26, v24
    v_mul_f32 v27, v27, v24
    v_mul_f32 v28, v28, v24
    v_mul_f32 v29, v29, v24
    v_cvt_pk_bf16_f32 v26, v26, v27
    v_cvt_pk_bf16_f32 v27, v28, v29
    v_lshlrev_b32 v25, 5, v0
    v_mov_b32 v40, 0
    v_mov_b32 v41, 0
    v_mov_b32 v42, 0
    v_mov_b32 v43, 0
    ds_write_b128 v25, v[40:43] offset:0
    ds_write_b128 v25, v[40:43] offset:16
    s_waitcnt lgkmcnt(0)
    s_barrier
    s_lshl_b32 s3, s20, 7
    v_lshl_add_u32 v25, v4, 3, s3
    v_cmp_gt_u32 vcc, 16, v1
    s_and_saveexec_b64 s[50:51], vcc
    ds_write_b64 v25, v[26:27] offset:0
    v_cmp_gt_u32 vcc, 7, v1
    s_and_b64 exec, exec, vcc
    s_mul_i32 s3, s2, 7
    s_mul_i32 s19, s20, 1792
    s_add_u32 s3, s3, s19
    v_add_u32 v31, s3, v1
    v_lshlrev_b32 v31, 1, v31
    v_add_u32 v31, 131072, v31
    buffer_load_ushort v31, v31, s[44:47], 0 offen
    v_sub_f32 v25, 1.0, v30
    s_waitcnt vmcnt(0)
    v_lshlrev_b32 v31, 16, v31
    v_mul_f32 v31, v31, v25
    v_cvt_pk_bf16_f32 v31, v31, v31
    s_lshl_b32 s3, s20, 6
    v_lshl_add_u32 v25, v1, 1, s3
    ds_write_b16 v25, v31 offset:6144
    s_mov_b64 exec, s[50:51]
    s_waitcnt vmcnt(0) lgkmcnt(0)
    s_barrier
    v_lshlrev_b32 v25, 7, v4
    v_lshl_add_u32 v25, v3, 4, v25
    ds_read_b128 v[64:67], v25 offset:0
    ds_read_b128 v[68:71], v25 offset:64
    v_and_b32 v9, 1, v3
    v_lshl_add_u32 v9, v9, 2, v5
    v_lshlrev_b32 v9, 1, v9
    v_lshl_add_u32 v12, v3, 3, v5
    v_and_b32 v13, 1, v6
    v_lshrrev_b32 v14, 1, v6
    v_lshlrev_b32 v15, 8, v12
    v_lshl_add_u32 v15, v13, 3, v15
    v_lshl_add_u32 v15, v14, 4, v15
    v_lshlrev_b32 v16, 10, v12
    v_lshl_add_u32 v16, v13, 3, v16
    v_lshl_add_u32 v16, v14, 4, v16
    v_mov_b32 v32, 0
    v_mov_b32 v33, 0
    v_mov_b32 v34, 0
    v_mov_b32 v35, 0
    v_mov_b32 v36, 0
    v_mov_b32 v37, 0
    v_mov_b32 v38, 0
    v_mov_b32 v39, 0
    s_lshl_b32 s3, s20, 2
    v_mov_b32 v13, s3
    v_add_u32 v13, 0, v13
    v_xor_b32 v13, v13, v9
    v_lshl_add_u32 v13, v13, 4, v15
    ds_read_b64_tr_b16 v[160:161], v13 offset:16384
    ds_read_b64_tr_b16 v[162:163], v13 offset:17408
    ds_read_b64_tr_b16 v[164:165], v13 offset:24576
    ds_read_b64_tr_b16 v[166:167], v13 offset:25600
    s_waitcnt lgkmcnt(0)
    v_mfma_f32_16x16x32_bf16 v[32:35], v[64:67], v[160:163], v[32:35]
    v_mfma_f32_16x16x32_bf16 v[32:35], v[68:71], v[164:167], v[32:35]
    v_mov_b32 v13, s3
    v_add_u32 v13, 2, v13
    v_xor_b32 v13, v13, v9
    v_lshl_add_u32 v13, v13, 4, v15
    ds_read_b64_tr_b16 v[160:161], v13 offset:16384
    ds_read_b64_tr_b16 v[162:163], v13 offset:17408
    ds_read_b64_tr_b16 v[164:165], v13 offset:24576
    ds_read_b64_tr_b16 v[166:167], v13 offset:25600
    s_waitcnt lgkmcnt(0)
    v_mfma_f32_16x16x32_bf16 v[36:39], v[64:67], v[160:163], v[36:39]
    v_mfma_f32_16x16x32_bf16 v[36:39], v[68:71], v[164:167], v[36:39]
    s_nop 7
    s_nop 7
    v_lshlrev_b32 v18, 10, v3
    v_lshl_add_u32 v18, v4, 1, v18
    s_lshl_b32 s3, s20, 6
    v_add_u32 v18, s3, v18
    v_cvt_pk_bf16_f32 v19, v32, v32
    ds_write_b16 v18, v19 offset:2048
    v_cvt_pk_bf16_f32 v19, v33, v33
    ds_write_b16 v18, v19 offset:2304
    v_cvt_pk_bf16_f32 v19, v34, v34
    ds_write_b16 v18, v19 offset:2560
    v_cvt_pk_bf16_f32 v19, v35, v35
    ds_write_b16 v18, v19 offset:2816
    v_cvt_pk_bf16_f32 v19, v36, v36
    ds_write_b16 v18, v19 offset:2080
    v_cvt_pk_bf16_f32 v19, v37, v37
    ds_write_b16 v18, v19 offset:2336
    v_cvt_pk_bf16_f32 v19, v38, v38
    ds_write_b16 v18, v19 offset:2592
    v_cvt_pk_bf16_f32 v19, v39, v39
    ds_write_b16 v18, v19 offset:2848
    s_waitcnt lgkmcnt(0)
    s_barrier
    v_lshlrev_b32 v25, 8, v4
    v_lshl_add_u32 v25, v3, 4, v25
    ds_read_b128 v[64:67], v25 offset:2048
    ds_read_b128 v[68:71], v25 offset:2112
    ds_read_b128 v[72:75], v25 offset:2176
    ds_read_b128 v[76:79], v25 offset:2240
    v_lshlrev_b32 v25, 6, v4
    v_lshl_add_u32 v25, v3, 4, v25
    ds_read_b128 v[80:83], v25 offset:6144
    v_lshlrev_b32 v17, 10, v5
    v_and_b32 v13, 1, v6
    v_lshl_add_u32 v17, v13, 3, v17
    v_lshl_add_u32 v17, v14, 4, v17
    v_lshlrev_b32 v19, 1, v5
    s_lshl_b32 s3, s20, 8
    v_add_u32 v16, s3, v16
    v_add_u32 v17, s3, v17
    v_add_u32 v16, 32768, v16
    s_lshl_b32 s3, s2, 13
    v_lshlrev_b32 v22, 11, v3
    v_lshl_add_u32 v22, v4, 2, v22
    v_add_u32 v22, s3, v22
    s_lshl_b32 s3, s20, 9
    v_add_u32 v22, s3, v22
    v_add_u32 v22, 16777216, v22
    v_add_u32 v23, 4096, v22
    s_mov_b32 s52, 0
K3_om:
    v_xor_b32 v11, s52, v9
    v_lshl_add_u32 v12, v11, 4, v16
    v_add_u32 v13, 0x10000, v12
    v_xor_b32 v11, s52, v19
    v_lshl_add_u32 v18, v11, 4, v17
    v_mov_b32 v48, 0
    v_mov_b32 v49, 0
    v_mov_b32 v50, 0
    v_mov_b32 v51, 0
    ds_read_b64_tr_b16 v[160:161], v12 offset:0
    ds_read_b64_tr_b16 v[162:163], v12 offset:4096
    ds_read_b64_tr_b16 v[164:165], v12 offset:32768
    ds_read_b64_tr_b16 v[166:167], v12 offset:36864
    ds_read_b64_tr_b16 v[168:169], v13 offset:0
    ds_read_b64_tr_b16 v[170:171], v13 offset:4096
    ds_read_b64_tr_b16 v[172:173], v13 offset:32768
    ds_read_b64_tr_b16 v[174:175], v13 offset:36864
    v_add_u32 v18, 8192, v18
    ds_read_b64_tr_b16 v[176:177], v18
    ds_read_b64_tr_b16 v[178:179], v18 offset:4096
    s_waitcnt lgkmcnt(0)
    v_mfma_f32_16x16x32_bf16 v[48:51], v[64:67], v[160:163], v[48:51]
    v_mfma_f32_16x16x32_bf16 v[48:51], v[68:71], v[164:167], v[48:51]
    v_mfma_f32_16x16x32_bf16 v[48:51], v[72:75], v[168:171], v[48:51]
    v_mfma_f32_16x16x32_bf16 v[48:51], v[76:79], v[172:175], v[48:51]
    v_mfma_f32_16x16x32_bf16 v[48:51], v[80:83], v[176:179], v[48:51]
    s_nop 7
    s_nop 1
    v_cmp_gt_u32 vcc, 16, v1
    s_and_saveexec_b64 s[50:51], vcc
    buffer_store_dword v48, v22, s[44:47], 0 offen offset:0
    buffer_store_dword v49, v22, s[44:47], 0 offen offset:2048
    buffer_store_dword v50, v23, s[44:47], 0 offen offset:0
    buffer_store_dword v51, v23, s[44:47], 0 offen offset:2048
    s_mov_b64 exec, s[50:51]
    v_add_u32 v22, 64, v22
    v_add_u32 v23, 64, v23
    s_add_u32 s52, s52, 2
    s_cmp_lt_u32 s52, 16
    s_cbranch_scc1 K3_om
K3_done:
    s_endpgm
.globl k4_sum_kernel
.p2align 8
.type k4_sum_kernel,@function
k4_sum_kernel:
    s_cmp_ge_u32 s2, 32
    s_cbranch_scc1 K4_done
    s_load_dwordx2 s[4:5], s[0:1], 88
    s_load_dwordx2 s[14:15], s[0:1], 104
    v_and_b32 v1, 63, v0
    v_lshrrev_b32 v2, 6, v0
    s_waitcnt lgkmcnt(0)
    s_mov_b32 s24, s4
    s_and_b32 s25, s5, 0xffff
    s_mov_b32 s26, 4096
    s_mov_b32 s27, 0x00020000
    s_mov_b32 s44, s14
    s_and_b32 s45, s15, 0xffff
    s_mov_b32 s46, 20971520
    s_mov_b32 s47, 0x00020000
    s_lshl_b32 s3, s2, 6
    v_add_u32 v3, s3, v1
    v_lshlrev_b32 v4, 2, v3
    v_lshl_add_u32 v4, v2, 19, v4
    v_add_u32 v4, 16777216, v4
    buffer_load_dword v16, v4, s[44:47], 0 offen
    v_add_u32 v4, 0x2000, v4
    buffer_load_dword v17, v4, s[44:47], 0 offen
    v_add_u32 v4, 0x2000, v4
    buffer_load_dword v18, v4, s[44:47], 0 offen
    v_add_u32 v4, 0x2000, v4
    buffer_load_dword v19, v4, s[44:47], 0 offen
    v_add_u32 v4, 0x2000, v4
    buffer_load_dword v20, v4, s[44:47], 0 offen
    v_add_u32 v4, 0x2000, v4
    buffer_load_dword v21, v4, s[44:47], 0 offen
    v_add_u32 v4, 0x2000, v4
    buffer_load_dword v22, v4, s[44:47], 0 offen
    v_add_u32 v4, 0x2000, v4
    buffer_load_dword v23, v4, s[44:47], 0 offen
    v_add_u32 v4, 0x2000, v4
    buffer_load_dword v24, v4, s[44:47], 0 offen
    v_add_u32 v4, 0x2000, v4
    buffer_load_dword v25, v4, s[44:47], 0 offen
    v_add_u32 v4, 0x2000, v4
    buffer_load_dword v26, v4, s[44:47], 0 offen
    v_add_u32 v4, 0x2000, v4
    buffer_load_dword v27, v4, s[44:47], 0 offen
    v_add_u32 v4, 0x2000, v4
    buffer_load_dword v28, v4, s[44:47], 0 offen
    v_add_u32 v4, 0x2000, v4
    buffer_load_dword v29, v4, s[44:47], 0 offen
    v_add_u32 v4, 0x2000, v4
    buffer_load_dword v30, v4, s[44:47], 0 offen
    v_add_u32 v4, 0x2000, v4
    buffer_load_dword v31, v4, s[44:47], 0 offen
    v_add_u32 v4, 0x2000, v4
    buffer_load_dword v32, v4, s[44:47], 0 offen
    v_add_u32 v4, 0x2000, v4
    buffer_load_dword v33, v4, s[44:47], 0 offen
    v_add_u32 v4, 0x2000, v4
    buffer_load_dword v34, v4, s[44:47], 0 offen
    v_add_u32 v4, 0x2000, v4
    buffer_load_dword v35, v4, s[44:47], 0 offen
    v_add_u32 v4, 0x2000, v4
    buffer_load_dword v36, v4, s[44:47], 0 offen
    v_add_u32 v4, 0x2000, v4
    buffer_load_dword v37, v4, s[44:47], 0 offen
    v_add_u32 v4, 0x2000, v4
    buffer_load_dword v38, v4, s[44:47], 0 offen
    v_add_u32 v4, 0x2000, v4
    buffer_load_dword v39, v4, s[44:47], 0 offen
    v_add_u32 v4, 0x2000, v4
    buffer_load_dword v40, v4, s[44:47], 0 offen
    v_add_u32 v4, 0x2000, v4
    buffer_load_dword v41, v4, s[44:47], 0 offen
    v_add_u32 v4, 0x2000, v4
    buffer_load_dword v42, v4, s[44:47], 0 offen
    v_add_u32 v4, 0x2000, v4
    buffer_load_dword v43, v4, s[44:47], 0 offen
    v_add_u32 v4, 0x2000, v4
    buffer_load_dword v44, v4, s[44:47], 0 offen
    v_add_u32 v4, 0x2000, v4
    buffer_load_dword v45, v4, s[44:47], 0 offen
    v_add_u32 v4, 0x2000, v4
    buffer_load_dword v46, v4, s[44:47], 0 offen
    v_add_u32 v4, 0x2000, v4
    buffer_load_dword v47, v4, s[44:47], 0 offen
    v_add_u32 v4, 0x2000, v4
    buffer_load_dword v48, v4, s[44:47], 0 offen
    v_add_u32 v4, 0x2000, v4
    buffer_load_dword v49, v4, s[44:47], 0 offen
    v_add_u32 v4, 0x2000, v4
    buffer_load_dword v50, v4, s[44:47], 0 offen
    v_add_u32 v4, 0x2000, v4
    buffer_load_dword v51, v4, s[44:47], 0 offen
    v_add_u32 v4, 0x2000, v4
    buffer_load_dword v52, v4, s[44:47], 0 offen
    v_add_u32 v4, 0x2000, v4
    buffer_load_dword v53, v4, s[44:47], 0 offen
    v_add_u32 v4, 0x2000, v4
    buffer_load_dword v54, v4, s[44:47], 0 offen
    v_add_u32 v4, 0x2000, v4
    buffer_load_dword v55, v4, s[44:47], 0 offen
    v_add_u32 v4, 0x2000, v4
    buffer_load_dword v56, v4, s[44:47], 0 offen
    v_add_u32 v4, 0x2000, v4
    buffer_load_dword v57, v4, s[44:47], 0 offen
    v_add_u32 v4, 0x2000, v4
    buffer_load_dword v58, v4, s[44:47], 0 offen
    v_add_u32 v4, 0x2000, v4
    buffer_load_dword v59, v4, s[44:47], 0 offen
    v_add_u32 v4, 0x2000, v4
    buffer_load_dword v60, v4, s[44:47], 0 offen
    v_add_u32 v4, 0x2000, v4
    buffer_load_dword v61, v4, s[44:47], 0 offen
    v_add_u32 v4, 0x2000, v4
    buffer_load_dword v62, v4, s[44:47], 0 offen
    v_add_u32 v4, 0x2000, v4
    buffer_load_dword v63, v4, s[44:47], 0 offen
    v_add_u32 v4, 0x2000, v4
    buffer_load_dword v64, v4, s[44:47], 0 offen
    v_add_u32 v4, 0x2000, v4
    buffer_load_dword v65, v4, s[44:47], 0 offen
    v_add_u32 v4, 0x2000, v4
    buffer_load_dword v66, v4, s[44:47], 0 offen
    v_add_u32 v4, 0x2000, v4
    buffer_load_dword v67, v4, s[44:47], 0 offen
    v_add_u32 v4, 0x2000, v4
    buffer_load_dword v68, v4, s[44:47], 0 offen
    v_add_u32 v4, 0x2000, v4
    buffer_load_dword v69, v4, s[44:47], 0 offen
    v_add_u32 v4, 0x2000, v4
    buffer_load_dword v70, v4, s[44:47], 0 offen
    v_add_u32 v4, 0x2000, v4
    buffer_load_dword v71, v4, s[44:47], 0 offen
    v_add_u32 v4, 0x2000, v4
    buffer_load_dword v72, v4, s[44:47], 0 offen
    v_add_u32 v4, 0x2000, v4
    buffer_load_dword v73, v4, s[44:47], 0 offen
    v_add_u32 v4, 0x2000, v4
    buffer_load_dword v74, v4, s[44:47], 0 offen
    v_add_u32 v4, 0x2000, v4
    buffer_load_dword v75, v4, s[44:47], 0 offen
    v_add_u32 v4, 0x2000, v4
    buffer_load_dword v76, v4, s[44:47], 0 offen
    v_add_u32 v4, 0x2000, v4
    buffer_load_dword v77, v4, s[44:47], 0 offen
    v_add_u32 v4, 0x2000, v4
    buffer_load_dword v78, v4, s[44:47], 0 offen
    v_add_u32 v4, 0x2000, v4
    buffer_load_dword v79, v4, s[44:47], 0 offen
    v_add_u32 v4, 0x2000, v4
    s_waitcnt vmcnt(0)
    v_add_f32 v16, v16, v48
    v_add_f32 v17, v17, v49
    v_add_f32 v18, v18, v50
    v_add_f32 v19, v19, v51
    v_add_f32 v20, v20, v52
    v_add_f32 v21, v21, v53
    v_add_f32 v22, v22, v54
    v_add_f32 v23, v23, v55
    v_add_f32 v24, v24, v56
    v_add_f32 v25, v25, v57
    v_add_f32 v26, v26, v58
    v_add_f32 v27, v27, v59
    v_add_f32 v28, v28, v60
    v_add_f32 v29, v29, v61
    v_add_f32 v30, v30, v62
    v_add_f32 v31, v31, v63
    v_add_f32 v32, v32, v64
    v_add_f32 v33, v33, v65
    v_add_f32 v34, v34, v66
    v_add_f32 v35, v35, v67
    v_add_f32 v36, v36, v68
    v_add_f32 v37, v37, v69
    v_add_f32 v38, v38, v70
    v_add_f32 v39, v39, v71
    v_add_f32 v40, v40, v72
    v_add_f32 v41, v41, v73
    v_add_f32 v42, v42, v74
    v_add_f32 v43, v43, v75
    v_add_f32 v44, v44, v76
    v_add_f32 v45, v45, v77
    v_add_f32 v46, v46, v78
    v_add_f32 v47, v47, v79
    v_add_f32 v16, v16, v32
    v_add_f32 v17, v17, v33
    v_add_f32 v18, v18, v34
    v_add_f32 v19, v19, v35
    v_add_f32 v20, v20, v36
    v_add_f32 v21, v21, v37
    v_add_f32 v22, v22, v38
    v_add_f32 v23, v23, v39
    v_add_f32 v24, v24, v40
    v_add_f32 v25, v25, v41
    v_add_f32 v26, v26, v42
    v_add_f32 v27, v27, v43
    v_add_f32 v28, v28, v44
    v_add_f32 v29, v29, v45
    v_add_f32 v30, v30, v46
    v_add_f32 v31, v31, v47
    v_add_f32 v16, v16, v24
    v_add_f32 v17, v17, v25
    v_add_f32 v18, v18, v26
    v_add_f32 v19, v19, v27
    v_add_f32 v20, v20, v28
    v_add_f32 v21, v21, v29
    v_add_f32 v22, v22, v30
    v_add_f32 v23, v23, v31
    v_add_f32 v16, v16, v20
    v_add_f32 v17, v17, v21
    v_add_f32 v18, v18, v22
    v_add_f32 v19, v19, v23
    v_add_f32 v16, v16, v18
    v_add_f32 v17, v17, v19
    v_add_f32 v16, v16, v17
    v_lshlrev_b32 v5, 2, v0
    ds_write_b32 v5, v16
    s_waitcnt lgkmcnt(0)
    s_barrier
    v_lshlrev_b32 v5, 2, v1
    ds_read_b32 v8, v5 offset:0
    ds_read_b32 v9, v5 offset:256
    ds_read_b32 v10, v5 offset:512
    ds_read_b32 v11, v5 offset:768
    s_waitcnt lgkmcnt(0)
    v_add_f32 v8, v8, v9
    v_add_f32 v10, v10, v11
    v_add_f32 v8, v8, v10
    v_cvt_pk_bf16_f32 v8, v8, v8
    v_lshlrev_b32 v3, 1, v3
    v_cmp_gt_u32 vcc, 64, v0
    s_and_saveexec_b64 s[50:51], vcc
    buffer_store_short v8, v3, s[24:27], 0 offen
K4_done:
    s_endpgm
.section .rodata,"a"
.p2align 6
.p2align 6
.amdhsa_kernel k1_prep_kernel
  .amdhsa_next_free_vgpr 192
  .amdhsa_next_free_sgpr 96
  .amdhsa_accum_offset 192
  .amdhsa_group_segment_fixed_size 0
  .amdhsa_kernarg_size 112
  .amdhsa_user_sgpr_count 2
  .amdhsa_user_sgpr_kernarg_segment_ptr 1
  .amdhsa_system_sgpr_workgroup_id_x 1
.end_amdhsa_kernel
.p2align 6
.amdhsa_kernel k2_attn_kernel
  .amdhsa_next_free_vgpr 192
  .amdhsa_next_free_sgpr 96
  .amdhsa_accum_offset 192
  .amdhsa_group_segment_fixed_size 0
  .amdhsa_kernarg_size 112
  .amdhsa_user_sgpr_count 2
  .amdhsa_user_sgpr_kernarg_segment_ptr 1
  .amdhsa_system_sgpr_workgroup_id_x 1
.end_amdhsa_kernel
.p2align 6
.amdhsa_kernel k3_proj_kernel
  .amdhsa_next_free_vgpr 180
  .amdhsa_next_free_sgpr 96
  .amdhsa_accum_offset 180
  .amdhsa_group_segment_fixed_size 0
  .amdhsa_kernarg_size 112
  .amdhsa_user_sgpr_count 2
  .amdhsa_user_sgpr_kernarg_segment_ptr 1
  .amdhsa_system_sgpr_workgroup_id_x 1
.end_amdhsa_kernel
.p2align 6
.amdhsa_kernel k4_sum_kernel
  .amdhsa_next_free_vgpr 80
  .amdhsa_next_free_sgpr 96
  .amdhsa_accum_offset 80
  .amdhsa_group_segment_fixed_size 0
  .amdhsa_kernarg_size 112
  .amdhsa_user_sgpr_count 2
  .amdhsa_user_sgpr_kernarg_segment_ptr 1
  .amdhsa_system_sgpr_workgroup_id_x 1
.end_amdhsa_kernel
```
